```python
import torch

def _softmax(x, axis=-1):
    return torch.softmax(x, dim=axis)
def _gelu(x):
    return torch.nn.functional.gelu(x, approximate="tanh")
def _silu(x):
    return torch.nn.functional.silu(x)
def _sigmoid(x):
    return torch.sigmoid(x)
def _layernorm(x, axis=-1, eps=1e-5):
    m = x.mean(dim=axis, keepdim=True)
    v = x.var(dim=axis, keepdim=True, unbiased=False)
    return (x - m) / torch.sqrt(v + eps)
def _scatter_add(tgt, idx, src, axis=0):
    return tgt.clone().index_add_(axis, idx, src)
def _segment_sum(src, seg, n):
    out = torch.zeros((n,) + src.shape[1:], dtype=src.dtype)
    return out.index_add_(0, seg, src)
def _pad(x, pw):
    flat = tuple(v for pair in reversed(pw) for v in pair)
    return torch.nn.functional.pad(x, flat)

kernel_name = 'standalone__deep_cross_wide_deep__recsys'

def setup_inputs():

    _w = (lambda a: (lambda t: t.to(torch.bfloat16) if t.is_floating_point() else t)(torch.as_tensor(a)))
    B, F, D = 16384, 26, 128
    V, Nd = min(1000000, 100000), 13
    Din = F * D
    H = 4 * D
    return {
        "idx": _w((lambda lo, hi, *s: torch.randint(lo, hi, s))(0, V, B, F).to(torch.int64)),
        "table": _w((lambda *s: torch.randn(*s, dtype=torch.bfloat16) * 1.6)(V, D) * 0.05),
        "x_wide": _w((lambda *s: torch.randn(*s, dtype=torch.bfloat16) * 1.6)(B, Nd)),
        "w_wide": _w((lambda *s: torch.randn(*s, dtype=torch.bfloat16) * 1.6)(Nd) * 0.05),
        "b_wide": _w((lambda *s: torch.randn(*s, dtype=torch.bfloat16) * 1.6)(1) * 0.01),
        "W1": _w((lambda *s: torch.randn(*s, dtype=torch.bfloat16) * 1.6)(Din, H) * (2.0 / Din) ** 0.5),
        "b1": _w((lambda *s: torch.randn(*s, dtype=torch.bfloat16) * 1.6)(H) * 0.01),
        "W2": _w((lambda *s: torch.randn(*s, dtype=torch.bfloat16) * 1.6)(H) * (1.0 / H) ** 0.5),
        "b2": _w((lambda *s: torch.randn(*s, dtype=torch.bfloat16) * 1.6)(1) * 0.01),
    }

def reference(idx, table, x_wide, w_wide, b_wide, W1, b1, W2, b2):
    emb = table[idx]
    deep_in = emb.reshape(emb.shape[0], -1)
    h = deep_in @ W1 + b1
    h = h * (lambda x, dt: x.to(dt))(h > 0, h.dtype)
    deep_logit = h @ W2 + b2
    wide_logit = x_wide @ w_wide + b_wide
    return _sigmoid(wide_logit + deep_logit)
```

```asm
; @launch grid=(256,1,1) block=(512,1,1) lds=163840
.amdgcn_target "amdgcn-amd-amdhsa--gfx950"
.text
.globl standalone__deep_cross_wide_deep__recsys_kernel
.p2align 8
.type standalone__deep_cross_wide_deep__recsys_kernel,@function
standalone__deep_cross_wide_deep__recsys_kernel:
    s_cmp_ge_u32 s2, 256
    s_cbranch_scc1 L_end
    s_load_dwordx16 s[16:31], s[0:1], 0
    s_load_dwordx8 s[32:39], s[0:1], 64
    v_lshrrev_b32 v1, 6, v0
    v_and_b32 v0, 63, v0
    v_readfirstlane_b32 s3, v1
    s_and_b32 s4, s2, 7
    s_lshr_b32 s5, s2, 3
    s_and_b32 s6, s5, 1
    s_lshr_b32 s7, s5, 1
    s_lshl_b32 s8, s4, 4
    s_add_u32 s8, s8, s7
    s_lshl_b32 s9, s8, 7
    s_lshl_b32 s10, s6, 9
    v_lshrrev_b32 v1, 4, v0
    v_and_b32 v2, 15, v0
    s_mov_b32 s50, 3407872
    s_mov_b32 s51, 0x00020000
    s_mov_b32 s43, 0x00020000
    s_mov_b32 s47, 0x00020000
    s_and_b32 s11, s3, 3
    s_lshl_b32 s58, s5, 11
    s_lshl_b32 s59, s11, 9
    s_add_u32 s58, s58, s59
    s_waitcnt lgkmcnt(0)
    s_mov_b32 s48, s26
    s_and_b32 s49, s27, 0xffff
    s_cmp_lt_u32 s3, 4
    s_cbranch_scc1 L_cons
    s_mov_b32 s40, s16
    s_and_b32 s41, s17, 0xffff
    s_mov_b32 s42, 1703936
    v_and_b32 v3, 7, v0
    v_lshl_add_u32 v3, v3, 2, v1
    s_lshl_b32 s12, s11, 5
    s_add_u32 s12, s12, s9
    v_add_u32 v3, s12, v3
    v_mul_u32_u24 v25, 104, v3
    buffer_load_dwordx4 v[64:67], v25, s[40:43], 0 offen
    v_bfe_u32 v3, v0, 2, 2
    v_and_b32 v4, 3, v0
    v_lshlrev_b32 v7, 10, v3
    v_lshl_add_u32 v7, v1, 6, v7
    v_add_u32 v7, s10, v7
    v_lshl_add_u32 v5, v4, 4, v7
    v_xor_b32 v6, 32, v5
    s_lshl_b32 s53, s11, 13
    s_add_u32 s12, s53, 65536
    s_add_u32 s15, s12, 98304
    s_mov_b32 s52, s12
    s_lshl_b32 s54, s11, 14
    s_mov_b32 s61, s54
    s_mov_b32 s60, 0
    s_mov_b32 s55, 1
    s_and_b32 s57, s7, 1
    s_sub_u32 s57, 2, s57
    s_mov_b32 s62, 0
    s_cmp_eq_u32 s11, 0
    s_cselect_b32 s73, 15, 0
    s_mov_b32 s63, 1
    s_mov_b32 s44, s18
    s_and_b32 s45, s19, 0xffff
    s_mov_b32 s46, 25600000
    v_xor_b32 v3, v2, v1
    v_lshlrev_b32 v20, 4, v3
    v_xor_b32 v21, 64, v20
    v_xor_b32 v22, 128, v20
    v_xor_b32 v23, 192, v20
    s_add_u32 s58, s58, 262144
    s_branch L_B
L_A:
    s_set_gpr_idx_on s60, gpr_idx(SRC1)
    s_nop 0
    v_lshlrev_b32 v24, 8, v64
    s_set_gpr_idx_off
    s_mov_b32 m0, s53
    s_xor_b32 s53, s53, 32768
    v_add_u32_dpp v32, v24, v20 row_newbcast:0 row_mask:0xf bank_mask:0xf
    v_add_u32_dpp v33, v24, v21 row_newbcast:1 row_mask:0xf bank_mask:0xf
    v_add_u32_dpp v34, v24, v22 row_newbcast:2 row_mask:0xf bank_mask:0xf
    v_add_u32_dpp v35, v24, v23 row_newbcast:3 row_mask:0xf bank_mask:0xf
    v_add_u32_dpp v36, v24, v20 row_newbcast:4 row_mask:0xf bank_mask:0xf
    v_add_u32_dpp v37, v24, v21 row_newbcast:5 row_mask:0xf bank_mask:0xf
    v_add_u32_dpp v38, v24, v22 row_newbcast:6 row_mask:0xf bank_mask:0xf
    v_add_u32_dpp v39, v24, v23 row_newbcast:7 row_mask:0xf bank_mask:0xf
    buffer_load_dwordx4 v32, s[44:47], 0 offen lds
    s_add_u32 m0, m0, 1024
    s_nop 0
    buffer_load_dwordx4 v33, s[44:47], 0 offen lds
    s_add_u32 m0, m0, 1024
    s_nop 0
    buffer_load_dwordx4 v34, s[44:47], 0 offen lds
    s_add_u32 m0, m0, 1024
    s_nop 0
    buffer_load_dwordx4 v35, s[44:47], 0 offen lds
    s_add_u32 m0, m0, 1024
    s_nop 0
    buffer_load_dwordx4 v36, s[44:47], 0 offen lds
    s_add_u32 m0, m0, 1024
    s_nop 0
    buffer_load_dwordx4 v37, s[44:47], 0 offen lds
    s_add_u32 m0, m0, 1024
    s_nop 0
    buffer_load_dwordx4 v38, s[44:47], 0 offen lds
    s_add_u32 m0, m0, 1024
    s_nop 0
    buffer_load_dwordx4 v39, s[44:47], 0 offen lds
L_A3:
    s_cmp_eq_u32 s63, 1
    s_cbranch_scc1 L_B
    s_buffer_load_dword s80, s[48:51], s58 offset:0
    s_buffer_load_dword s80, s[48:51], s58 offset:64
    s_buffer_load_dword s80, s[48:51], s58 offset:128
    s_buffer_load_dword s80, s[48:51], s58 offset:192
    s_buffer_load_dword s80, s[48:51], s58 offset:256
    s_buffer_load_dword s80, s[48:51], s58 offset:320
    s_buffer_load_dword s80, s[48:51], s58 offset:384
    s_buffer_load_dword s80, s[48:51], s58 offset:448
    s_add_u32 s58, s58, 65536
    s_waitcnt vmcnt(8)
    s_barrier
L_B:
    s_mov_b32 m0, s12
    s_mov_b32 s13, s61
    buffer_load_dwordx4 v5, s[48:51], s13 offen lds
    s_add_u32 m0, m0, 1024
    s_add_u32 s13, s13, 256
    buffer_load_dwordx4 v5, s[48:51], s13 offen lds
    s_add_u32 m0, m0, 1024
    s_add_u32 s13, s13, 3840
    buffer_load_dwordx4 v5, s[48:51], s13 offen lds
    s_add_u32 m0, m0, 1024
    s_add_u32 s13, s13, 256
    buffer_load_dwordx4 v5, s[48:51], s13 offen lds
    s_add_u32 m0, m0, 1024
    s_add_u32 s13, s13, 3840
    buffer_load_dwordx4 v6, s[48:51], s13 offen lds
    s_add_u32 m0, m0, 1024
    s_add_u32 s13, s13, 256
    buffer_load_dwordx4 v6, s[48:51], s13 offen lds
    s_add_u32 m0, m0, 1024
    s_add_u32 s13, s13, 3840
    buffer_load_dwordx4 v6, s[48:51], s13 offen lds
    s_add_u32 m0, m0, 1024
    s_add_u32 s13, s13, 256
    buffer_load_dwordx4 v6, s[48:51], s13 offen lds
    s_add_u32 s61, s61, 65536
    s_add_u32 s12, s12, 32768
    s_cmp_ge_u32 s12, s15
    s_cselect_b32 s12, s52, s12
    s_xor_b32 s62, s62, 1
    s_cbranch_scc0 L_Bdone
    s_cmp_eq_u32 s63, 0
    s_cbranch_scc1 L_B
    s_cmp_eq_u32 s63, 2
    s_cbranch_scc1 L_idx
    s_waitcnt vmcnt(8)
    s_branch L_A
L_idx:
    buffer_load_dwordx4 v[68:71], v25, s[40:43], 0 offen offset:16
    buffer_load_dwordx4 v[72:75], v25, s[40:43], 0 offen offset:32
    buffer_load_dwordx4 v[76:79], v25, s[40:43], 0 offen offset:48
    buffer_load_dwordx4 v[80:83], v25, s[40:43], 0 offen offset:64
    buffer_load_dwordx4 v[84:87], v25, s[40:43], 0 offen offset:80
    buffer_load_dwordx2 v[88:89], v25, s[40:43], 0 offen offset:96
    s_cmp_lg_u32 s11, 0
    s_cbranch_scc1 L_B
    s_mov_b32 s40, s20
    s_and_b32 s41, s21, 0xffff
    s_mov_b32 s42, 425984
    s_mul_i32 s14, s9, 26
    v_mul_u32_u24 v4, 52, v0
    buffer_load_dwordx4 v[96:99], v4, s[40:43], s14 offen
    buffer_load_dwordx4 v[100:103], v4, s[40:43], s14 offen offset:16
    buffer_load_dwordx4 v[104:107], v4, s[40:43], s14 offen offset:32
    buffer_load_dword v108, v4, s[40:43], s14 offen offset:48
    s_load_dwordx4 s[64:67], s[22:23], 0
    s_load_dwordx2 s[68:69], s[22:23], 16
    s_load_dword s70, s[22:23], 24
    s_load_dword s71, s[24:25], 0
    s_branch L_B
L_Bdone:
    s_buffer_load_dword s80, s[48:51], s58 offset:0
    s_buffer_load_dword s80, s[48:51], s58 offset:64
    s_buffer_load_dword s80, s[48:51], s58 offset:128
    s_buffer_load_dword s80, s[48:51], s58 offset:192
    s_buffer_load_dword s80, s[48:51], s58 offset:256
    s_buffer_load_dword s80, s[48:51], s58 offset:320
    s_buffer_load_dword s80, s[48:51], s58 offset:384
    s_buffer_load_dword s80, s[48:51], s58 offset:448
    s_add_u32 s58, s58, 65536
    s_sub_u32 s60, s55, s57
    s_xor_b32 s60, s60, s6
    s_add_u32 s60, s60, s57
    s_min_i32 s60, s60, 25
    s_cmp_lt_u32 s55, s57
    s_cselect_b32 s60, s55, s60
    s_lshl_b32 s61, s60, 17
    s_add_u32 s61, s61, s54
    s_add_u32 s55, s55, 1
    s_lshl_b32 s63, s63, 1
    s_and_b32 s63, s63, 2
    s_waitcnt vmcnt(8)
    s_barrier
    s_cmp_eq_u32 s55, s73
    s_cbranch_scc1 L_wide
L_wret:
    s_cmp_lt_u32 s55, 27
    s_cbranch_scc1 L_A
    s_waitcnt vmcnt(0)
    s_barrier
    v_lshlrev_b32 v3, 3, v0
    s_cmp_lg_u32 s11, 0
    s_cbranch_scc1 L_lend
    ds_write_b64 v3, v[90:91] offset:8192
L_lend:
    s_waitcnt lgkmcnt(0)
    s_endpgm
L_wide:
    s_waitcnt lgkmcnt(0)
    s_mov_b32 s14, 0xffff0000
    v_mov_b32 v90, 0
    v_mov_b32 v91, 0
    s_lshl_b32 s72, s64, 16
    v_lshlrev_b32 v30, 16, v96
    v_fmac_f32 v90, s72, v30
    v_and_b32 v30, s14, v102
    v_fmac_f32 v91, s72, v30
    s_and_b32 s72, s64, s14
    v_and_b32 v30, s14, v96
    v_fmac_f32 v90, s72, v30
    v_lshlrev_b32 v30, 16, v103
    v_fmac_f32 v91, s72, v30
    s_lshl_b32 s72, s65, 16
    v_lshlrev_b32 v30, 16, v97
    v_fmac_f32 v90, s72, v30
    v_and_b32 v30, s14, v103
    v_fmac_f32 v91, s72, v30
    s_and_b32 s72, s65, s14
    v_and_b32 v30, s14, v97
    v_fmac_f32 v90, s72, v30
    v_lshlrev_b32 v30, 16, v104
    v_fmac_f32 v91, s72, v30
    s_lshl_b32 s72, s66, 16
    v_lshlrev_b32 v30, 16, v98
    v_fmac_f32 v90, s72, v30
    v_and_b32 v30, s14, v104
    v_fmac_f32 v91, s72, v30
    s_and_b32 s72, s66, s14
    v_and_b32 v30, s14, v98
    v_fmac_f32 v90, s72, v30
    v_lshlrev_b32 v30, 16, v105
    v_fmac_f32 v91, s72, v30
    s_lshl_b32 s72, s67, 16
    v_lshlrev_b32 v30, 16, v99
    v_fmac_f32 v90, s72, v30
    v_and_b32 v30, s14, v105
    v_fmac_f32 v91, s72, v30
    s_and_b32 s72, s67, s14
    v_and_b32 v30, s14, v99
    v_fmac_f32 v90, s72, v30
    v_lshlrev_b32 v30, 16, v106
    v_fmac_f32 v91, s72, v30
    s_lshl_b32 s72, s68, 16
    v_lshlrev_b32 v30, 16, v100
    v_fmac_f32 v90, s72, v30
    v_and_b32 v30, s14, v106
    v_fmac_f32 v91, s72, v30
    s_and_b32 s72, s68, s14
    v_and_b32 v30, s14, v100
    v_fmac_f32 v90, s72, v30
    v_lshlrev_b32 v30, 16, v107
    v_fmac_f32 v91, s72, v30
    s_lshl_b32 s72, s69, 16
    v_lshlrev_b32 v30, 16, v101
    v_fmac_f32 v90, s72, v30
    v_and_b32 v30, s14, v107
    v_fmac_f32 v91, s72, v30
    s_and_b32 s72, s69, s14
    v_and_b32 v30, s14, v101
    v_fmac_f32 v90, s72, v30
    v_lshlrev_b32 v30, 16, v108
    v_fmac_f32 v91, s72, v30
    s_lshl_b32 s72, s70, 16
    v_lshlrev_b32 v30, 16, v102
    v_fmac_f32 v90, s72, v30
    v_and_b32 v30, s14, v108
    v_fmac_f32 v91, s72, v30
    s_lshl_b32 s71, s71, 16
    v_cvt_pk_bf16_f32 v30, v90, v91
    v_lshlrev_b32 v90, 16, v30
    v_and_b32 v91, s14, v30
    v_add_f32 v90, s71, v90
    v_add_f32 v91, s71, v91
    v_cvt_pk_bf16_f32 v30, v90, v91
    v_lshlrev_b32 v90, 16, v30
    v_and_b32 v91, s14, v30
    s_branch L_wret
L_cons:
    s_mov_b32 s40, s28
    s_and_b32 s41, s29, 0xffff
    s_mov_b32 s42, 1024
    s_mov_b32 s44, s30
    s_and_b32 s45, s31, 0xffff
    s_mov_b32 s46, 1024
    s_lshl_b32 s11, s3, 7
    s_add_u32 s11, s11, s10
    v_lshl_add_u32 v3, v1, 3, s11
    buffer_load_dwordx2 v[96:97], v3, s[40:43], 0 offen offset:0
    buffer_load_dwordx2 v[98:99], v3, s[40:43], 0 offen offset:32
    buffer_load_dwordx2 v[100:101], v3, s[40:43], 0 offen offset:64
    buffer_load_dwordx2 v[102:103], v3, s[40:43], 0 offen offset:96
    buffer_load_dwordx2 v[112:113], v3, s[44:47], 0 offen offset:0
    buffer_load_dwordx2 v[114:115], v3, s[44:47], 0 offen offset:32
    buffer_load_dwordx2 v[116:117], v3, s[44:47], 0 offen offset:64
    buffer_load_dwordx2 v[118:119], v3, s[44:47], 0 offen offset:96
    s_load_dword s64, s[32:33], 0
    s_add_u32 s58, s58, 131072
    s_mov_b32 s12, 2
L_cpf:
    s_buffer_load_dword s80, s[48:51], s58 offset:0
    s_buffer_load_dword s80, s[48:51], s58 offset:64
    s_buffer_load_dword s80, s[48:51], s58 offset:128
    s_buffer_load_dword s80, s[48:51], s58 offset:192
    s_buffer_load_dword s80, s[48:51], s58 offset:256
    s_buffer_load_dword s80, s[48:51], s58 offset:320
    s_buffer_load_dword s80, s[48:51], s58 offset:384
    s_buffer_load_dword s80, s[48:51], s58 offset:448
    s_add_u32 s58, s58, 65536
    s_sub_u32 s12, s12, 1
    s_cmp_lg_u32 s12, 0
    s_cbranch_scc1 L_cpf
    s_setprio 2
    v_xor_b32 v3, v1, v2
    v_lshlrev_b32 v3, 4, v3
    v_lshl_add_u32 v4, v2, 8, v3
    v_xor_b32 v5, 64, v4
    v_xor_b32 v6, 128, v4
    v_xor_b32 v7, 192, v4
    v_lshlrev_b32 v12, 12, v1
    v_lshrrev_b32 v3, 2, v2
    v_lshl_add_u32 v12, v3, 6, v12
    v_and_b32 v3, 3, v2
    v_lshl_add_u32 v12, v3, 3, v12
    s_lshl_b32 s11, s3, 9
    v_add_u32 v12, s11, v12
    v_and_b32 v3, 1, v1
    v_lshl_add_u32 v12, v3, 5, v12
    v_xor_b32 v13, 32, v12
    s_mov_b32 s13, 65536
    v_add_u32 v10, s13, v12
    v_add_u32 v11, s13, v13
    s_mov_b32 s14, 0xffff0000
    s_mov_b32 s15, 0x8000
    s_waitcnt vmcnt(4)
L_ini:
    s_set_gpr_idx_on s12, gpr_idx(DST)
    s_nop 0
    v_lshlrev_b32 v128, 16, v96
    v_and_b32 v129, s14, v96
    v_lshlrev_b32 v130, 16, v97
    v_and_b32 v131, s14, v97
    v_lshlrev_b32 v132, 16, v98
    v_and_b32 v133, s14, v98
    v_lshlrev_b32 v134, 16, v99
    v_and_b32 v135, s14, v99
    v_lshlrev_b32 v136, 16, v100
    v_and_b32 v137, s14, v100
    v_lshlrev_b32 v138, 16, v101
    v_and_b32 v139, s14, v101
    v_lshlrev_b32 v140, 16, v102
    v_and_b32 v141, s14, v102
    v_lshlrev_b32 v142, 16, v103
    v_and_b32 v143, s14, v103
    s_set_gpr_idx_off
    s_add_u32 s12, s12, 16
    s_cmp_lt_u32 s12, 128
    s_cbranch_scc1 L_ini
    s_mov_b32 s12, 0
    s_waitcnt vmcnt(0)
    s_barrier
    ds_read_b64_tr_b16 v[16:17], v10 offset:0
    ds_read_b64_tr_b16 v[18:19], v10 offset:2048
    ds_read_b64_tr_b16 v[20:21], v10 offset:16384
    ds_read_b64_tr_b16 v[22:23], v10 offset:18432
    ds_read_b64_tr_b16 v[24:25], v11 offset:0
    ds_read_b64_tr_b16 v[26:27], v11 offset:2048
    ds_read_b64_tr_b16 v[28:29], v11 offset:16384
    ds_read_b64_tr_b16 v[30:31], v11 offset:18432
    ds_read_b128 v[80:83], v4 offset:0
    ds_read_b128 v[84:87], v5 offset:0
    ds_read_b128 v[88:91], v4 offset:4096
    ds_read_b128 v[92:95], v5 offset:4096
    ds_read_b64_tr_b16 v[32:33], v10 offset:256
    ds_read_b64_tr_b16 v[34:35], v10 offset:2304
    ds_read_b64_tr_b16 v[36:37], v10 offset:16640
    ds_read_b64_tr_b16 v[38:39], v10 offset:18688
    ds_read_b64_tr_b16 v[40:41], v11 offset:256
    ds_read_b64_tr_b16 v[42:43], v11 offset:2304
    ds_read_b64_tr_b16 v[44:45], v11 offset:16640
    ds_read_b64_tr_b16 v[46:47], v11 offset:18688
L_cloop:
    s_waitcnt lgkmcnt(0)
    v_mfma_f32_16x16x32_bf16 v[128:131], v[16:19], v[80:83], v[128:131]
    ds_read_b128 v[96:99], v4 offset:8192
    v_mfma_f32_16x16x32_bf16 v[128:131], v[20:23], v[84:87], v[128:131]
    ds_read_b128 v[100:103], v5 offset:8192
    v_mfma_f32_16x16x32_bf16 v[144:147], v[20:23], v[92:95], v[144:147]
    ds_read_b128 v[104:107], v4 offset:12288
    v_mfma_f32_16x16x32_bf16 v[144:147], v[16:19], v[88:91], v[144:147]
    ds_read_b128 v[108:111], v5 offset:12288
    v_mfma_f32_16x16x32_bf16 v[148:151], v[24:27], v[88:91], v[148:151]
    v_mfma_f32_16x16x32_bf16 v[148:151], v[28:31], v[92:95], v[148:151]
    v_mfma_f32_16x16x32_bf16 v[132:135], v[28:31], v[84:87], v[132:135]
    v_mfma_f32_16x16x32_bf16 v[132:135], v[24:27], v[80:83], v[132:135]
    v_mfma_f32_16x16x32_bf16 v[136:139], v[32:35], v[80:83], v[136:139]
    v_mfma_f32_16x16x32_bf16 v[136:139], v[36:39], v[84:87], v[136:139]
    v_mfma_f32_16x16x32_bf16 v[152:155], v[36:39], v[92:95], v[152:155]
    v_mfma_f32_16x16x32_bf16 v[152:155], v[32:35], v[88:91], v[152:155]
    v_mfma_f32_16x16x32_bf16 v[156:159], v[40:43], v[88:91], v[156:159]
    v_mfma_f32_16x16x32_bf16 v[156:159], v[44:47], v[92:95], v[156:159]
    v_mfma_f32_16x16x32_bf16 v[140:143], v[44:47], v[84:87], v[140:143]
    v_mfma_f32_16x16x32_bf16 v[140:143], v[40:43], v[80:83], v[140:143]
    s_waitcnt lgkmcnt(0)
    v_mfma_f32_16x16x32_bf16 v[172:175], v[40:43], v[96:99], v[172:175]
    ds_read_b128 v[80:83], v4 offset:16384
    v_mfma_f32_16x16x32_bf16 v[172:175], v[44:47], v[100:103], v[172:175]
    ds_read_b128 v[84:87], v5 offset:16384
    v_mfma_f32_16x16x32_bf16 v[188:191], v[44:47], v[108:111], v[188:191]
    ds_read_b128 v[88:91], v4 offset:20480
    v_mfma_f32_16x16x32_bf16 v[188:191], v[40:43], v[104:107], v[188:191]
    ds_read_b128 v[92:95], v5 offset:20480
    v_mfma_f32_16x16x32_bf16 v[184:187], v[32:35], v[104:107], v[184:187]
    v_mfma_f32_16x16x32_bf16 v[184:187], v[36:39], v[108:111], v[184:187]
    v_mfma_f32_16x16x32_bf16 v[168:171], v[36:39], v[100:103], v[168:171]
    v_mfma_f32_16x16x32_bf16 v[168:171], v[32:35], v[96:99], v[168:171]
    v_mfma_f32_16x16x32_bf16 v[164:167], v[24:27], v[96:99], v[164:167]
    v_mfma_f32_16x16x32_bf16 v[164:167], v[28:31], v[100:103], v[164:167]
    v_mfma_f32_16x16x32_bf16 v[180:183], v[28:31], v[108:111], v[180:183]
    s_add_u32 s12, s12, 1
    v_mfma_f32_16x16x32_bf16 v[180:183], v[24:27], v[104:107], v[180:183]
    s_add_u32 s13, s13, 32768
    v_mfma_f32_16x16x32_bf16 v[176:179], v[16:19], v[104:107], v[176:179]
    s_cmp_ge_u32 s13, 163840
    v_mfma_f32_16x16x32_bf16 v[176:179], v[20:23], v[108:111], v[176:179]
    s_cselect_b32 s13, 65536, s13
    v_mfma_f32_16x16x32_bf16 v[160:163], v[20:23], v[100:103], v[160:163]
    v_add_u32 v10, s13, v12
    v_mfma_f32_16x16x32_bf16 v[160:163], v[16:19], v[96:99], v[160:163]
    v_add_u32 v11, s13, v13
    s_waitcnt lgkmcnt(0)
    v_mfma_f32_16x16x32_bf16 v[192:195], v[16:19], v[80:83], v[192:195]
    ds_read_b128 v[96:99], v4 offset:24576
    v_mfma_f32_16x16x32_bf16 v[192:195], v[20:23], v[84:87], v[192:195]
    ds_read_b128 v[100:103], v5 offset:24576
    v_mfma_f32_16x16x32_bf16 v[208:211], v[20:23], v[92:95], v[208:211]
    ds_read_b128 v[104:107], v4 offset:28672
    v_mfma_f32_16x16x32_bf16 v[208:211], v[16:19], v[88:91], v[208:211]
    ds_read_b128 v[108:111], v5 offset:28672
    v_mfma_f32_16x16x32_bf16 v[212:215], v[24:27], v[88:91], v[212:215]
    v_xor_b32 v4, s15, v4
    v_mfma_f32_16x16x32_bf16 v[212:215], v[28:31], v[92:95], v[212:215]
    v_xor_b32 v5, s15, v5
    v_mfma_f32_16x16x32_bf16 v[196:199], v[28:31], v[84:87], v[196:199]
    v_mfma_f32_16x16x32_bf16 v[196:199], v[24:27], v[80:83], v[196:199]
    s_waitcnt lgkmcnt(0)
    s_barrier
    v_mfma_f32_16x16x32_bf16 v[200:203], v[32:35], v[80:83], v[200:203]
    ds_read_b64_tr_b16 v[48:49], v10 offset:0
    v_mfma_f32_16x16x32_bf16 v[200:203], v[36:39], v[84:87], v[200:203]
    ds_read_b64_tr_b16 v[50:51], v10 offset:2048
    v_mfma_f32_16x16x32_bf16 v[216:219], v[36:39], v[92:95], v[216:219]
    ds_read_b64_tr_b16 v[52:53], v10 offset:16384
    v_mfma_f32_16x16x32_bf16 v[216:219], v[32:35], v[88:91], v[216:219]
    ds_read_b64_tr_b16 v[54:55], v10 offset:18432
    v_mfma_f32_16x16x32_bf16 v[220:223], v[40:43], v[88:91], v[220:223]
    ds_read_b64_tr_b16 v[56:57], v11 offset:0
    v_mfma_f32_16x16x32_bf16 v[220:223], v[44:47], v[92:95], v[220:223]
    ds_read_b64_tr_b16 v[58:59], v11 offset:2048
    v_mfma_f32_16x16x32_bf16 v[204:207], v[44:47], v[84:87], v[204:207]
    ds_read_b64_tr_b16 v[60:61], v11 offset:16384
    v_mfma_f32_16x16x32_bf16 v[204:207], v[40:43], v[80:83], v[204:207]
    ds_read_b64_tr_b16 v[62:63], v11 offset:18432
    v_mfma_f32_16x16x32_bf16 v[236:239], v[40:43], v[96:99], v[236:239]
    ds_read_b128 v[80:83], v6 offset:0
    v_mfma_f32_16x16x32_bf16 v[236:239], v[44:47], v[100:103], v[236:239]
    ds_read_b128 v[84:87], v7 offset:0
    v_mfma_f32_16x16x32_bf16 v[252:255], v[44:47], v[108:111], v[252:255]
    ds_read_b128 v[88:91], v6 offset:4096
    v_mfma_f32_16x16x32_bf16 v[252:255], v[40:43], v[104:107], v[252:255]
    ds_read_b128 v[92:95], v7 offset:4096
    v_mfma_f32_16x16x32_bf16 v[248:251], v[32:35], v[104:107], v[248:251]
    ds_read_b64_tr_b16 v[64:65], v10 offset:256
    v_mfma_f32_16x16x32_bf16 v[248:251], v[36:39], v[108:111], v[248:251]
    ds_read_b64_tr_b16 v[66:67], v10 offset:2304
    v_mfma_f32_16x16x32_bf16 v[232:235], v[36:39], v[100:103], v[232:235]
    ds_read_b64_tr_b16 v[68:69], v10 offset:16640
    v_mfma_f32_16x16x32_bf16 v[232:235], v[32:35], v[96:99], v[232:235]
    ds_read_b64_tr_b16 v[70:71], v10 offset:18688
    v_mfma_f32_16x16x32_bf16 v[228:231], v[24:27], v[96:99], v[228:231]
    ds_read_b64_tr_b16 v[72:73], v11 offset:256
    v_mfma_f32_16x16x32_bf16 v[228:231], v[28:31], v[100:103], v[228:231]
    ds_read_b64_tr_b16 v[74:75], v11 offset:2304
    v_mfma_f32_16x16x32_bf16 v[244:247], v[28:31], v[108:111], v[244:247]
    ds_read_b64_tr_b16 v[76:77], v11 offset:16640
    v_mfma_f32_16x16x32_bf16 v[244:247], v[24:27], v[104:107], v[244:247]
    ds_read_b64_tr_b16 v[78:79], v11 offset:18688
    v_mfma_f32_16x16x32_bf16 v[240:243], v[16:19], v[104:107], v[240:243]
    v_mfma_f32_16x16x32_bf16 v[240:243], v[20:23], v[108:111], v[240:243]
    v_mfma_f32_16x16x32_bf16 v[224:227], v[20:23], v[100:103], v[224:227]
    v_mfma_f32_16x16x32_bf16 v[224:227], v[16:19], v[96:99], v[224:227]
    s_waitcnt lgkmcnt(0)
    v_mfma_f32_16x16x32_bf16 v[128:131], v[48:51], v[80:83], v[128:131]
    ds_read_b128 v[96:99], v6 offset:8192
    v_mfma_f32_16x16x32_bf16 v[128:131], v[52:55], v[84:87], v[128:131]
    ds_read_b128 v[100:103], v7 offset:8192
    v_mfma_f32_16x16x32_bf16 v[144:147], v[52:55], v[92:95], v[144:147]
    ds_read_b128 v[104:107], v6 offset:12288
    v_mfma_f32_16x16x32_bf16 v[144:147], v[48:51], v[88:91], v[144:147]
    ds_read_b128 v[108:111], v7 offset:12288
    v_mfma_f32_16x16x32_bf16 v[148:151], v[56:59], v[88:91], v[148:151]
    v_mfma_f32_16x16x32_bf16 v[148:151], v[60:63], v[92:95], v[148:151]
    v_mfma_f32_16x16x32_bf16 v[132:135], v[60:63], v[84:87], v[132:135]
    v_mfma_f32_16x16x32_bf16 v[132:135], v[56:59], v[80:83], v[132:135]
    v_mfma_f32_16x16x32_bf16 v[136:139], v[64:67], v[80:83], v[136:139]
    v_mfma_f32_16x16x32_bf16 v[136:139], v[68:71], v[84:87], v[136:139]
    v_mfma_f32_16x16x32_bf16 v[152:155], v[68:71], v[92:95], v[152:155]
    v_mfma_f32_16x16x32_bf16 v[152:155], v[64:67], v[88:91], v[152:155]
    v_mfma_f32_16x16x32_bf16 v[156:159], v[72:75], v[88:91], v[156:159]
    v_mfma_f32_16x16x32_bf16 v[156:159], v[76:79], v[92:95], v[156:159]
    v_mfma_f32_16x16x32_bf16 v[140:143], v[76:79], v[84:87], v[140:143]
    v_mfma_f32_16x16x32_bf16 v[140:143], v[72:75], v[80:83], v[140:143]
    s_waitcnt lgkmcnt(0)
    v_mfma_f32_16x16x32_bf16 v[172:175], v[72:75], v[96:99], v[172:175]
    ds_read_b128 v[80:83], v6 offset:16384
    v_mfma_f32_16x16x32_bf16 v[172:175], v[76:79], v[100:103], v[172:175]
    ds_read_b128 v[84:87], v7 offset:16384
    v_mfma_f32_16x16x32_bf16 v[188:191], v[76:79], v[108:111], v[188:191]
    ds_read_b128 v[88:91], v6 offset:20480
    v_mfma_f32_16x16x32_bf16 v[188:191], v[72:75], v[104:107], v[188:191]
    ds_read_b128 v[92:95], v7 offset:20480
    v_mfma_f32_16x16x32_bf16 v[184:187], v[64:67], v[104:107], v[184:187]
    v_mfma_f32_16x16x32_bf16 v[184:187], v[68:71], v[108:111], v[184:187]
    v_mfma_f32_16x16x32_bf16 v[168:171], v[68:71], v[100:103], v[168:171]
    v_mfma_f32_16x16x32_bf16 v[168:171], v[64:67], v[96:99], v[168:171]
    v_mfma_f32_16x16x32_bf16 v[164:167], v[56:59], v[96:99], v[164:167]
    v_mfma_f32_16x16x32_bf16 v[164:167], v[60:63], v[100:103], v[164:167]
    v_mfma_f32_16x16x32_bf16 v[180:183], v[60:63], v[108:111], v[180:183]
    s_add_u32 s12, s12, 1
    v_mfma_f32_16x16x32_bf16 v[180:183], v[56:59], v[104:107], v[180:183]
    s_add_u32 s13, s13, 32768
    v_mfma_f32_16x16x32_bf16 v[176:179], v[48:51], v[104:107], v[176:179]
    s_cmp_ge_u32 s13, 163840
    v_mfma_f32_16x16x32_bf16 v[176:179], v[52:55], v[108:111], v[176:179]
    s_cselect_b32 s13, 65536, s13
    v_mfma_f32_16x16x32_bf16 v[160:163], v[52:55], v[100:103], v[160:163]
    v_add_u32 v10, s13, v12
    v_mfma_f32_16x16x32_bf16 v[160:163], v[48:51], v[96:99], v[160:163]
    v_add_u32 v11, s13, v13
    s_waitcnt lgkmcnt(0)
    v_mfma_f32_16x16x32_bf16 v[192:195], v[48:51], v[80:83], v[192:195]
    ds_read_b128 v[96:99], v6 offset:24576
    v_mfma_f32_16x16x32_bf16 v[192:195], v[52:55], v[84:87], v[192:195]
    ds_read_b128 v[100:103], v7 offset:24576
    v_mfma_f32_16x16x32_bf16 v[208:211], v[52:55], v[92:95], v[208:211]
    ds_read_b128 v[104:107], v6 offset:28672
    v_mfma_f32_16x16x32_bf16 v[208:211], v[48:51], v[88:91], v[208:211]
    ds_read_b128 v[108:111], v7 offset:28672
    v_mfma_f32_16x16x32_bf16 v[212:215], v[56:59], v[88:91], v[212:215]
    v_xor_b32 v6, s15, v6
    v_mfma_f32_16x16x32_bf16 v[212:215], v[60:63], v[92:95], v[212:215]
    v_xor_b32 v7, s15, v7
    v_mfma_f32_16x16x32_bf16 v[196:199], v[60:63], v[84:87], v[196:199]
    v_mfma_f32_16x16x32_bf16 v[196:199], v[56:59], v[80:83], v[196:199]
    s_waitcnt lgkmcnt(0)
    s_barrier
    v_mfma_f32_16x16x32_bf16 v[200:203], v[64:67], v[80:83], v[200:203]
    ds_read_b64_tr_b16 v[16:17], v10 offset:0
    v_mfma_f32_16x16x32_bf16 v[200:203], v[68:71], v[84:87], v[200:203]
    ds_read_b64_tr_b16 v[18:19], v10 offset:2048
    v_mfma_f32_16x16x32_bf16 v[216:219], v[68:71], v[92:95], v[216:219]
    ds_read_b64_tr_b16 v[20:21], v10 offset:16384
    v_mfma_f32_16x16x32_bf16 v[216:219], v[64:67], v[88:91], v[216:219]
    ds_read_b64_tr_b16 v[22:23], v10 offset:18432
    v_mfma_f32_16x16x32_bf16 v[220:223], v[72:75], v[88:91], v[220:223]
    ds_read_b64_tr_b16 v[24:25], v11 offset:0
    v_mfma_f32_16x16x32_bf16 v[220:223], v[76:79], v[92:95], v[220:223]
    ds_read_b64_tr_b16 v[26:27], v11 offset:2048
    v_mfma_f32_16x16x32_bf16 v[204:207], v[76:79], v[84:87], v[204:207]
    ds_read_b64_tr_b16 v[28:29], v11 offset:16384
    v_mfma_f32_16x16x32_bf16 v[204:207], v[72:75], v[80:83], v[204:207]
    ds_read_b64_tr_b16 v[30:31], v11 offset:18432
    v_mfma_f32_16x16x32_bf16 v[236:239], v[72:75], v[96:99], v[236:239]
    ds_read_b128 v[80:83], v4 offset:0
    v_mfma_f32_16x16x32_bf16 v[236:239], v[76:79], v[100:103], v[236:239]
    ds_read_b128 v[84:87], v5 offset:0
    v_mfma_f32_16x16x32_bf16 v[252:255], v[76:79], v[108:111], v[252:255]
    ds_read_b128 v[88:91], v4 offset:4096
    v_mfma_f32_16x16x32_bf16 v[252:255], v[72:75], v[104:107], v[252:255]
    ds_read_b128 v[92:95], v5 offset:4096
    v_mfma_f32_16x16x32_bf16 v[248:251], v[64:67], v[104:107], v[248:251]
    ds_read_b64_tr_b16 v[32:33], v10 offset:256
    v_mfma_f32_16x16x32_bf16 v[248:251], v[68:71], v[108:111], v[248:251]
    ds_read_b64_tr_b16 v[34:35], v10 offset:2304
    v_mfma_f32_16x16x32_bf16 v[232:235], v[68:71], v[100:103], v[232:235]
    ds_read_b64_tr_b16 v[36:37], v10 offset:16640
    v_mfma_f32_16x16x32_bf16 v[232:235], v[64:67], v[96:99], v[232:235]
    ds_read_b64_tr_b16 v[38:39], v10 offset:18688
    v_mfma_f32_16x16x32_bf16 v[228:231], v[56:59], v[96:99], v[228:231]
    ds_read_b64_tr_b16 v[40:41], v11 offset:256
    v_mfma_f32_16x16x32_bf16 v[228:231], v[60:63], v[100:103], v[228:231]
    ds_read_b64_tr_b16 v[42:43], v11 offset:2304
    v_mfma_f32_16x16x32_bf16 v[244:247], v[60:63], v[108:111], v[244:247]
    ds_read_b64_tr_b16 v[44:45], v11 offset:16640
    v_mfma_f32_16x16x32_bf16 v[244:247], v[56:59], v[104:107], v[244:247]
    ds_read_b64_tr_b16 v[46:47], v11 offset:18688
    v_mfma_f32_16x16x32_bf16 v[240:243], v[48:51], v[104:107], v[240:243]
    v_mfma_f32_16x16x32_bf16 v[240:243], v[52:55], v[108:111], v[240:243]
    v_mfma_f32_16x16x32_bf16 v[224:227], v[52:55], v[100:103], v[224:227]
    s_cmp_lt_u32 s12, 50
    v_mfma_f32_16x16x32_bf16 v[224:227], v[48:51], v[96:99], v[224:227]
    s_cbranch_scc1 L_cloop
    s_waitcnt lgkmcnt(0)
    v_mfma_f32_16x16x32_bf16 v[128:131], v[16:19], v[80:83], v[128:131]
    ds_read_b128 v[96:99], v4 offset:8192
    v_mfma_f32_16x16x32_bf16 v[128:131], v[20:23], v[84:87], v[128:131]
    ds_read_b128 v[100:103], v5 offset:8192
    v_mfma_f32_16x16x32_bf16 v[144:147], v[20:23], v[92:95], v[144:147]
    ds_read_b128 v[104:107], v4 offset:12288
    v_mfma_f32_16x16x32_bf16 v[144:147], v[16:19], v[88:91], v[144:147]
    ds_read_b128 v[108:111], v5 offset:12288
    v_mfma_f32_16x16x32_bf16 v[148:151], v[24:27], v[88:91], v[148:151]
    v_mfma_f32_16x16x32_bf16 v[148:151], v[28:31], v[92:95], v[148:151]
    v_mfma_f32_16x16x32_bf16 v[132:135], v[28:31], v[84:87], v[132:135]
    v_mfma_f32_16x16x32_bf16 v[132:135], v[24:27], v[80:83], v[132:135]
    v_mfma_f32_16x16x32_bf16 v[136:139], v[32:35], v[80:83], v[136:139]
    v_mfma_f32_16x16x32_bf16 v[136:139], v[36:39], v[84:87], v[136:139]
    v_mfma_f32_16x16x32_bf16 v[152:155], v[36:39], v[92:95], v[152:155]
    v_mfma_f32_16x16x32_bf16 v[152:155], v[32:35], v[88:91], v[152:155]
    v_mfma_f32_16x16x32_bf16 v[156:159], v[40:43], v[88:91], v[156:159]
    v_mfma_f32_16x16x32_bf16 v[156:159], v[44:47], v[92:95], v[156:159]
    v_mfma_f32_16x16x32_bf16 v[140:143], v[44:47], v[84:87], v[140:143]
    v_mfma_f32_16x16x32_bf16 v[140:143], v[40:43], v[80:83], v[140:143]
    s_waitcnt lgkmcnt(0)
    v_mfma_f32_16x16x32_bf16 v[172:175], v[40:43], v[96:99], v[172:175]
    ds_read_b128 v[80:83], v4 offset:16384
    v_mfma_f32_16x16x32_bf16 v[172:175], v[44:47], v[100:103], v[172:175]
    ds_read_b128 v[84:87], v5 offset:16384
    v_mfma_f32_16x16x32_bf16 v[188:191], v[44:47], v[108:111], v[188:191]
    ds_read_b128 v[88:91], v4 offset:20480
    v_mfma_f32_16x16x32_bf16 v[188:191], v[40:43], v[104:107], v[188:191]
    ds_read_b128 v[92:95], v5 offset:20480
    v_mfma_f32_16x16x32_bf16 v[184:187], v[32:35], v[104:107], v[184:187]
    v_mfma_f32_16x16x32_bf16 v[184:187], v[36:39], v[108:111], v[184:187]
    v_mfma_f32_16x16x32_bf16 v[168:171], v[36:39], v[100:103], v[168:171]
    v_mfma_f32_16x16x32_bf16 v[168:171], v[32:35], v[96:99], v[168:171]
    v_mfma_f32_16x16x32_bf16 v[164:167], v[24:27], v[96:99], v[164:167]
    v_mfma_f32_16x16x32_bf16 v[164:167], v[28:31], v[100:103], v[164:167]
    v_mfma_f32_16x16x32_bf16 v[180:183], v[28:31], v[108:111], v[180:183]
    s_add_u32 s12, s12, 1
    v_mfma_f32_16x16x32_bf16 v[180:183], v[24:27], v[104:107], v[180:183]
    s_add_u32 s13, s13, 32768
    v_mfma_f32_16x16x32_bf16 v[176:179], v[16:19], v[104:107], v[176:179]
    s_cmp_ge_u32 s13, 163840
    v_mfma_f32_16x16x32_bf16 v[176:179], v[20:23], v[108:111], v[176:179]
    s_cselect_b32 s13, 65536, s13
    v_mfma_f32_16x16x32_bf16 v[160:163], v[20:23], v[100:103], v[160:163]
    v_add_u32 v10, s13, v12
    v_mfma_f32_16x16x32_bf16 v[160:163], v[16:19], v[96:99], v[160:163]
    v_add_u32 v11, s13, v13
    s_waitcnt lgkmcnt(0)
    v_mfma_f32_16x16x32_bf16 v[192:195], v[16:19], v[80:83], v[192:195]
    ds_read_b128 v[96:99], v4 offset:24576
    v_mfma_f32_16x16x32_bf16 v[192:195], v[20:23], v[84:87], v[192:195]
    ds_read_b128 v[100:103], v5 offset:24576
    v_mfma_f32_16x16x32_bf16 v[208:211], v[20:23], v[92:95], v[208:211]
    ds_read_b128 v[104:107], v4 offset:28672
    v_mfma_f32_16x16x32_bf16 v[208:211], v[16:19], v[88:91], v[208:211]
    ds_read_b128 v[108:111], v5 offset:28672
    v_mfma_f32_16x16x32_bf16 v[212:215], v[24:27], v[88:91], v[212:215]
    v_xor_b32 v4, s15, v4
    v_mfma_f32_16x16x32_bf16 v[212:215], v[28:31], v[92:95], v[212:215]
    v_xor_b32 v5, s15, v5
    v_mfma_f32_16x16x32_bf16 v[196:199], v[28:31], v[84:87], v[196:199]
    v_mfma_f32_16x16x32_bf16 v[196:199], v[24:27], v[80:83], v[196:199]
    s_waitcnt lgkmcnt(0)
    s_barrier
    v_mfma_f32_16x16x32_bf16 v[200:203], v[32:35], v[80:83], v[200:203]
    ds_read_b64_tr_b16 v[48:49], v10 offset:0
    v_mfma_f32_16x16x32_bf16 v[200:203], v[36:39], v[84:87], v[200:203]
    ds_read_b64_tr_b16 v[50:51], v10 offset:2048
    v_mfma_f32_16x16x32_bf16 v[216:219], v[36:39], v[92:95], v[216:219]
    ds_read_b64_tr_b16 v[52:53], v10 offset:16384
    v_mfma_f32_16x16x32_bf16 v[216:219], v[32:35], v[88:91], v[216:219]
    ds_read_b64_tr_b16 v[54:55], v10 offset:18432
    v_mfma_f32_16x16x32_bf16 v[220:223], v[40:43], v[88:91], v[220:223]
    ds_read_b64_tr_b16 v[56:57], v11 offset:0
    v_mfma_f32_16x16x32_bf16 v[220:223], v[44:47], v[92:95], v[220:223]
    ds_read_b64_tr_b16 v[58:59], v11 offset:2048
    v_mfma_f32_16x16x32_bf16 v[204:207], v[44:47], v[84:87], v[204:207]
    ds_read_b64_tr_b16 v[60:61], v11 offset:16384
    v_mfma_f32_16x16x32_bf16 v[204:207], v[40:43], v[80:83], v[204:207]
    ds_read_b64_tr_b16 v[62:63], v11 offset:18432
    v_mfma_f32_16x16x32_bf16 v[236:239], v[40:43], v[96:99], v[236:239]
    ds_read_b128 v[80:83], v6 offset:0
    v_mfma_f32_16x16x32_bf16 v[236:239], v[44:47], v[100:103], v[236:239]
    ds_read_b128 v[84:87], v7 offset:0
    v_mfma_f32_16x16x32_bf16 v[252:255], v[44:47], v[108:111], v[252:255]
    ds_read_b128 v[88:91], v6 offset:4096
    v_mfma_f32_16x16x32_bf16 v[252:255], v[40:43], v[104:107], v[252:255]
    ds_read_b128 v[92:95], v7 offset:4096
    v_mfma_f32_16x16x32_bf16 v[248:251], v[32:35], v[104:107], v[248:251]
    ds_read_b64_tr_b16 v[64:65], v10 offset:256
    v_mfma_f32_16x16x32_bf16 v[248:251], v[36:39], v[108:111], v[248:251]
    ds_read_b64_tr_b16 v[66:67], v10 offset:2304
    v_mfma_f32_16x16x32_bf16 v[232:235], v[36:39], v[100:103], v[232:235]
    ds_read_b64_tr_b16 v[68:69], v10 offset:16640
    v_mfma_f32_16x16x32_bf16 v[232:235], v[32:35], v[96:99], v[232:235]
    ds_read_b64_tr_b16 v[70:71], v10 offset:18688
    v_mfma_f32_16x16x32_bf16 v[228:231], v[24:27], v[96:99], v[228:231]
    ds_read_b64_tr_b16 v[72:73], v11 offset:256
    v_mfma_f32_16x16x32_bf16 v[228:231], v[28:31], v[100:103], v[228:231]
    ds_read_b64_tr_b16 v[74:75], v11 offset:2304
    v_mfma_f32_16x16x32_bf16 v[244:247], v[28:31], v[108:111], v[244:247]
    ds_read_b64_tr_b16 v[76:77], v11 offset:16640
    v_mfma_f32_16x16x32_bf16 v[244:247], v[24:27], v[104:107], v[244:247]
    ds_read_b64_tr_b16 v[78:79], v11 offset:18688
    v_mfma_f32_16x16x32_bf16 v[240:243], v[16:19], v[104:107], v[240:243]
    v_mfma_f32_16x16x32_bf16 v[240:243], v[20:23], v[108:111], v[240:243]
    v_mfma_f32_16x16x32_bf16 v[224:227], v[20:23], v[100:103], v[224:227]
    v_mfma_f32_16x16x32_bf16 v[224:227], v[16:19], v[96:99], v[224:227]
    v_lshlrev_b32 v3, 9, v1
    v_lshl_add_u32 v3, v2, 2, v3
    s_lshl_b32 s11, s3, 11
    v_add_u32 v3, s11, v3
    s_waitcnt lgkmcnt(0)
    v_mfma_f32_16x16x32_bf16 v[128:131], v[48:51], v[80:83], v[128:131]
    ds_read_b128 v[96:99], v6 offset:8192
    v_mfma_f32_16x16x32_bf16 v[128:131], v[52:55], v[84:87], v[128:131]
    ds_read_b128 v[100:103], v7 offset:8192
    v_mfma_f32_16x16x32_bf16 v[144:147], v[52:55], v[92:95], v[144:147]
    ds_read_b128 v[104:107], v6 offset:12288
    v_mfma_f32_16x16x32_bf16 v[144:147], v[48:51], v[88:91], v[144:147]
    ds_read_b128 v[108:111], v7 offset:12288
    v_mfma_f32_16x16x32_bf16 v[148:151], v[56:59], v[88:91], v[148:151]
    v_mfma_f32_16x16x32_bf16 v[148:151], v[60:63], v[92:95], v[148:151]
    v_mfma_f32_16x16x32_bf16 v[132:135], v[60:63], v[84:87], v[132:135]
    v_mfma_f32_16x16x32_bf16 v[132:135], v[56:59], v[80:83], v[132:135]
    v_mfma_f32_16x16x32_bf16 v[136:139], v[64:67], v[80:83], v[136:139]
    v_mfma_f32_16x16x32_bf16 v[136:139], v[68:71], v[84:87], v[136:139]
    v_mfma_f32_16x16x32_bf16 v[152:155], v[68:71], v[92:95], v[152:155]
    v_mfma_f32_16x16x32_bf16 v[152:155], v[64:67], v[88:91], v[152:155]
    v_mfma_f32_16x16x32_bf16 v[156:159], v[72:75], v[88:91], v[156:159]
    v_mfma_f32_16x16x32_bf16 v[156:159], v[76:79], v[92:95], v[156:159]
    v_mfma_f32_16x16x32_bf16 v[140:143], v[76:79], v[84:87], v[140:143]
    v_mfma_f32_16x16x32_bf16 v[140:143], v[72:75], v[80:83], v[140:143]
    s_waitcnt lgkmcnt(0)
    v_mfma_f32_16x16x32_bf16 v[172:175], v[72:75], v[96:99], v[172:175]
    ds_read_b128 v[80:83], v6 offset:16384
    v_mfma_f32_16x16x32_bf16 v[172:175], v[76:79], v[100:103], v[172:175]
    ds_read_b128 v[84:87], v7 offset:16384
    v_mfma_f32_16x16x32_bf16 v[188:191], v[76:79], v[108:111], v[188:191]
    ds_read_b128 v[88:91], v6 offset:20480
    v_mfma_f32_16x16x32_bf16 v[188:191], v[72:75], v[104:107], v[188:191]
    ds_read_b128 v[92:95], v7 offset:20480
    v_mfma_f32_16x16x32_bf16 v[184:187], v[64:67], v[104:107], v[184:187]
    v_mfma_f32_16x16x32_bf16 v[184:187], v[68:71], v[108:111], v[184:187]
    v_mfma_f32_16x16x32_bf16 v[168:171], v[68:71], v[100:103], v[168:171]
    v_mfma_f32_16x16x32_bf16 v[168:171], v[64:67], v[96:99], v[168:171]
    v_cvt_pk_bf16_f32 v16, v128, v129
    v_pk_max_i16 v16, v16, 0
    v_mfma_f32_16x16x32_bf16 v[164:167], v[56:59], v[96:99], v[164:167]
    v_cvt_pk_bf16_f32 v17, v130, v131
    v_pk_max_i16 v17, v17, 0
    v_mfma_f32_16x16x32_bf16 v[164:167], v[60:63], v[100:103], v[164:167]
    v_cvt_pk_bf16_f32 v18, v132, v133
    v_pk_max_i16 v18, v18, 0
    v_mfma_f32_16x16x32_bf16 v[180:183], v[60:63], v[108:111], v[180:183]
    v_cvt_pk_bf16_f32 v19, v134, v135
    v_pk_max_i16 v19, v19, 0
    v_mfma_f32_16x16x32_bf16 v[180:183], v[56:59], v[104:107], v[180:183]
    v_cvt_pk_bf16_f32 v20, v136, v137
    v_pk_max_i16 v20, v20, 0
    v_mfma_f32_16x16x32_bf16 v[176:179], v[48:51], v[104:107], v[176:179]
    v_cvt_pk_bf16_f32 v21, v138, v139
    v_pk_max_i16 v21, v21, 0
    v_mfma_f32_16x16x32_bf16 v[176:179], v[52:55], v[108:111], v[176:179]
    v_cvt_pk_bf16_f32 v22, v140, v141
    v_pk_max_i16 v22, v22, 0
    v_mfma_f32_16x16x32_bf16 v[160:163], v[52:55], v[100:103], v[160:163]
    v_cvt_pk_bf16_f32 v23, v142, v143
    v_pk_max_i16 v23, v23, 0
    v_mfma_f32_16x16x32_bf16 v[160:163], v[48:51], v[96:99], v[160:163]
    v_cvt_pk_bf16_f32 v24, v144, v145
    v_pk_max_i16 v24, v24, 0
    s_waitcnt lgkmcnt(0)
    v_mfma_f32_16x16x32_bf16 v[192:195], v[48:51], v[80:83], v[192:195]
    ds_read_b128 v[96:99], v6 offset:24576
    v_dot2_f32_bf16 v32, v16, v112, 0
    v_mfma_f32_16x16x32_bf16 v[192:195], v[52:55], v[84:87], v[192:195]
    ds_read_b128 v[100:103], v7 offset:24576
    v_cvt_pk_bf16_f32 v25, v146, v147
    v_mfma_f32_16x16x32_bf16 v[208:211], v[52:55], v[92:95], v[208:211]
    ds_read_b128 v[104:107], v6 offset:28672
    v_pk_max_i16 v25, v25, 0
    v_mfma_f32_16x16x32_bf16 v[208:211], v[48:51], v[88:91], v[208:211]
    ds_read_b128 v[108:111], v7 offset:28672
    v_dot2_f32_bf16 v32, v17, v113, v32
    v_mfma_f32_16x16x32_bf16 v[212:215], v[56:59], v[88:91], v[212:215]
    v_cvt_pk_bf16_f32 v26, v148, v149
    v_pk_max_i16 v26, v26, 0
    v_mfma_f32_16x16x32_bf16 v[212:215], v[60:63], v[92:95], v[212:215]
    v_dot2_f32_bf16 v32, v18, v114, v32
    v_cvt_pk_bf16_f32 v27, v150, v151
    v_mfma_f32_16x16x32_bf16 v[196:199], v[60:63], v[84:87], v[196:199]
    v_pk_max_i16 v27, v27, 0
    v_dot2_f32_bf16 v32, v19, v115, v32
    v_mfma_f32_16x16x32_bf16 v[196:199], v[56:59], v[80:83], v[196:199]
    v_cvt_pk_bf16_f32 v28, v152, v153
    v_pk_max_i16 v28, v28, 0
    v_mfma_f32_16x16x32_bf16 v[200:203], v[64:67], v[80:83], v[200:203]
    v_dot2_f32_bf16 v32, v20, v116, v32
    v_cvt_pk_bf16_f32 v29, v154, v155
    v_mfma_f32_16x16x32_bf16 v[200:203], v[68:71], v[84:87], v[200:203]
    v_pk_max_i16 v29, v29, 0
    v_dot2_f32_bf16 v32, v21, v117, v32
    v_mfma_f32_16x16x32_bf16 v[216:219], v[68:71], v[92:95], v[216:219]
    v_cvt_pk_bf16_f32 v30, v156, v157
    v_pk_max_i16 v30, v30, 0
    v_mfma_f32_16x16x32_bf16 v[216:219], v[64:67], v[88:91], v[216:219]
    v_dot2_f32_bf16 v32, v22, v118, v32
    v_cvt_pk_bf16_f32 v31, v158, v159
    v_mfma_f32_16x16x32_bf16 v[220:223], v[72:75], v[88:91], v[220:223]
    v_pk_max_i16 v31, v31, 0
    v_dot2_f32_bf16 v32, v23, v119, v32
    v_mfma_f32_16x16x32_bf16 v[220:223], v[76:79], v[92:95], v[220:223]
    v_cvt_pk_bf16_f32 v16, v160, v161
    v_pk_max_i16 v16, v16, 0
    v_mfma_f32_16x16x32_bf16 v[204:207], v[76:79], v[84:87], v[204:207]
    v_dot2_f32_bf16 v33, v24, v112, 0
    v_cvt_pk_bf16_f32 v17, v162, v163
    v_mfma_f32_16x16x32_bf16 v[204:207], v[72:75], v[80:83], v[204:207]
    v_pk_max_i16 v17, v17, 0
    v_dot2_f32_bf16 v33, v25, v113, v33
    s_waitcnt lgkmcnt(0)
    v_mfma_f32_16x16x32_bf16 v[236:239], v[72:75], v[96:99], v[236:239]
    v_cvt_pk_bf16_f32 v18, v164, v165
    v_pk_max_i16 v18, v18, 0
    v_mfma_f32_16x16x32_bf16 v[236:239], v[76:79], v[100:103], v[236:239]
    v_dot2_f32_bf16 v33, v26, v114, v33
    v_cvt_pk_bf16_f32 v19, v166, v167
    v_mfma_f32_16x16x32_bf16 v[252:255], v[76:79], v[108:111], v[252:255]
    v_pk_max_i16 v19, v19, 0
    v_dot2_f32_bf16 v33, v27, v115, v33
    v_mfma_f32_16x16x32_bf16 v[252:255], v[72:75], v[104:107], v[252:255]
    v_cvt_pk_bf16_f32 v20, v168, v169
    v_pk_max_i16 v20, v20, 0
    v_mfma_f32_16x16x32_bf16 v[248:251], v[64:67], v[104:107], v[248:251]
    v_dot2_f32_bf16 v33, v28, v116, v33
    v_cvt_pk_bf16_f32 v21, v170, v171
    v_mfma_f32_16x16x32_bf16 v[248:251], v[68:71], v[108:111], v[248:251]
    v_pk_max_i16 v21, v21, 0
    v_dot2_f32_bf16 v33, v29, v117, v33
    v_mfma_f32_16x16x32_bf16 v[232:235], v[68:71], v[100:103], v[232:235]
    v_cvt_pk_bf16_f32 v22, v172, v173
    v_pk_max_i16 v22, v22, 0
    v_mfma_f32_16x16x32_bf16 v[232:235], v[64:67], v[96:99], v[232:235]
    v_dot2_f32_bf16 v33, v30, v118, v33
    v_cvt_pk_bf16_f32 v23, v174, v175
    v_mfma_f32_16x16x32_bf16 v[228:231], v[56:59], v[96:99], v[228:231]
    v_pk_max_i16 v23, v23, 0
    v_dot2_f32_bf16 v33, v31, v119, v33
    v_mfma_f32_16x16x32_bf16 v[228:231], v[60:63], v[100:103], v[228:231]
    v_cvt_pk_bf16_f32 v24, v176, v177
    v_pk_max_i16 v24, v24, 0
    v_mfma_f32_16x16x32_bf16 v[244:247], v[60:63], v[108:111], v[244:247]
    v_dot2_f32_bf16 v34, v16, v112, 0
    v_cvt_pk_bf16_f32 v25, v178, v179
    v_mfma_f32_16x16x32_bf16 v[244:247], v[56:59], v[104:107], v[244:247]
    v_pk_max_i16 v25, v25, 0
    v_dot2_f32_bf16 v34, v17, v113, v34
    v_mfma_f32_16x16x32_bf16 v[240:243], v[48:51], v[104:107], v[240:243]
    v_cvt_pk_bf16_f32 v26, v180, v181
    v_pk_max_i16 v26, v26, 0
    v_mfma_f32_16x16x32_bf16 v[240:243], v[52:55], v[108:111], v[240:243]
    v_dot2_f32_bf16 v34, v18, v114, v34
    v_cvt_pk_bf16_f32 v27, v182, v183
    v_mfma_f32_16x16x32_bf16 v[224:227], v[52:55], v[100:103], v[224:227]
    v_pk_max_i16 v27, v27, 0
    v_dot2_f32_bf16 v34, v19, v115, v34
    v_mfma_f32_16x16x32_bf16 v[224:227], v[48:51], v[96:99], v[224:227]
    v_cvt_pk_bf16_f32 v28, v184, v185
    v_pk_max_i16 v28, v28, 0
    s_nop 7
    v_dot2_f32_bf16 v34, v20, v116, v34
    v_cvt_pk_bf16_f32 v29, v186, v187
    v_pk_max_i16 v29, v29, 0
    v_dot2_f32_bf16 v34, v21, v117, v34
    v_cvt_pk_bf16_f32 v30, v188, v189
    v_pk_max_i16 v30, v30, 0
    v_dot2_f32_bf16 v34, v22, v118, v34
    v_cvt_pk_bf16_f32 v31, v190, v191
    v_pk_max_i16 v31, v31, 0
    v_dot2_f32_bf16 v34, v23, v119, v34
    v_cvt_pk_bf16_f32 v16, v192, v193
    v_pk_max_i16 v16, v16, 0
    v_dot2_f32_bf16 v35, v24, v112, 0
    v_cvt_pk_bf16_f32 v17, v194, v195
    v_pk_max_i16 v17, v17, 0
    v_dot2_f32_bf16 v35, v25, v113, v35
    v_cvt_pk_bf16_f32 v18, v196, v197
    v_pk_max_i16 v18, v18, 0
    v_dot2_f32_bf16 v35, v26, v114, v35
    v_cvt_pk_bf16_f32 v19, v198, v199
    v_pk_max_i16 v19, v19, 0
    v_dot2_f32_bf16 v35, v27, v115, v35
    v_cvt_pk_bf16_f32 v20, v200, v201
    v_pk_max_i16 v20, v20, 0
    v_dot2_f32_bf16 v35, v28, v116, v35
    v_cvt_pk_bf16_f32 v21, v202, v203
    v_pk_max_i16 v21, v21, 0
    v_dot2_f32_bf16 v35, v29, v117, v35
    v_cvt_pk_bf16_f32 v22, v204, v205
    v_pk_max_i16 v22, v22, 0
    v_dot2_f32_bf16 v35, v30, v118, v35
    v_cvt_pk_bf16_f32 v23, v206, v207
    v_pk_max_i16 v23, v23, 0
    v_dot2_f32_bf16 v35, v31, v119, v35
    v_cvt_pk_bf16_f32 v24, v208, v209
    v_pk_max_i16 v24, v24, 0
    v_dot2_f32_bf16 v36, v16, v112, 0
    v_cvt_pk_bf16_f32 v25, v210, v211
    v_pk_max_i16 v25, v25, 0
    v_dot2_f32_bf16 v36, v17, v113, v36
    v_cvt_pk_bf16_f32 v26, v212, v213
    v_pk_max_i16 v26, v26, 0
    v_dot2_f32_bf16 v36, v18, v114, v36
    v_cvt_pk_bf16_f32 v27, v214, v215
    v_pk_max_i16 v27, v27, 0
    v_dot2_f32_bf16 v36, v19, v115, v36
    v_cvt_pk_bf16_f32 v28, v216, v217
    v_pk_max_i16 v28, v28, 0
    v_dot2_f32_bf16 v36, v20, v116, v36
    v_cvt_pk_bf16_f32 v29, v218, v219
    v_pk_max_i16 v29, v29, 0
    v_dot2_f32_bf16 v36, v21, v117, v36
    v_cvt_pk_bf16_f32 v30, v220, v221
    v_pk_max_i16 v30, v30, 0
    v_dot2_f32_bf16 v36, v22, v118, v36
    v_cvt_pk_bf16_f32 v31, v222, v223
    v_pk_max_i16 v31, v31, 0
    v_dot2_f32_bf16 v36, v23, v119, v36
    v_cvt_pk_bf16_f32 v16, v224, v225
    v_pk_max_i16 v16, v16, 0
    v_dot2_f32_bf16 v37, v24, v112, 0
    v_cvt_pk_bf16_f32 v17, v226, v227
    v_pk_max_i16 v17, v17, 0
    v_dot2_f32_bf16 v37, v25, v113, v37
    v_cvt_pk_bf16_f32 v18, v228, v229
    v_pk_max_i16 v18, v18, 0
    v_dot2_f32_bf16 v37, v26, v114, v37
    v_cvt_pk_bf16_f32 v19, v230, v231
    v_pk_max_i16 v19, v19, 0
    v_dot2_f32_bf16 v37, v27, v115, v37
    v_cvt_pk_bf16_f32 v20, v232, v233
    v_pk_max_i16 v20, v20, 0
    v_dot2_f32_bf16 v37, v28, v116, v37
    v_cvt_pk_bf16_f32 v21, v234, v235
    v_pk_max_i16 v21, v21, 0
    v_dot2_f32_bf16 v37, v29, v117, v37
    v_cvt_pk_bf16_f32 v22, v236, v237
    v_pk_max_i16 v22, v22, 0
    v_dot2_f32_bf16 v37, v30, v118, v37
    v_cvt_pk_bf16_f32 v23, v238, v239
    v_pk_max_i16 v23, v23, 0
    v_dot2_f32_bf16 v37, v31, v119, v37
    v_cvt_pk_bf16_f32 v24, v240, v241
    v_pk_max_i16 v24, v24, 0
    v_dot2_f32_bf16 v38, v16, v112, 0
    v_cvt_pk_bf16_f32 v25, v242, v243
    v_pk_max_i16 v25, v25, 0
    v_dot2_f32_bf16 v38, v17, v113, v38
    v_cvt_pk_bf16_f32 v26, v244, v245
    v_pk_max_i16 v26, v26, 0
    v_dot2_f32_bf16 v38, v18, v114, v38
    v_cvt_pk_bf16_f32 v27, v246, v247
    v_pk_max_i16 v27, v27, 0
    v_dot2_f32_bf16 v38, v19, v115, v38
    v_cvt_pk_bf16_f32 v28, v248, v249
    v_pk_max_i16 v28, v28, 0
    v_dot2_f32_bf16 v38, v20, v116, v38
    v_cvt_pk_bf16_f32 v29, v250, v251
    v_pk_max_i16 v29, v29, 0
    v_dot2_f32_bf16 v38, v21, v117, v38
    v_cvt_pk_bf16_f32 v30, v252, v253
    v_pk_max_i16 v30, v30, 0
    v_dot2_f32_bf16 v38, v22, v118, v38
    v_cvt_pk_bf16_f32 v31, v254, v255
    v_pk_max_i16 v31, v31, 0
    v_dot2_f32_bf16 v38, v23, v119, v38
    v_dot2_f32_bf16 v39, v24, v112, 0
    v_dot2_f32_bf16 v39, v25, v113, v39
    v_dot2_f32_bf16 v39, v26, v114, v39
    v_dot2_f32_bf16 v39, v27, v115, v39
    v_dot2_f32_bf16 v39, v28, v116, v39
    v_dot2_f32_bf16 v39, v29, v117, v39
    v_dot2_f32_bf16 v39, v30, v118, v39
    v_dot2_f32_bf16 v39, v31, v119, v39
    s_nop 2
    ds_write_b32 v3, v32 offset:0
    ds_write_b32 v3, v33 offset:64
    ds_write_b32 v3, v34 offset:128
    ds_write_b32 v3, v35 offset:192
    ds_write_b32 v3, v36 offset:256
    ds_write_b32 v3, v37 offset:320
    ds_write_b32 v3, v38 offset:384
    ds_write_b32 v3, v39 offset:448
    s_waitcnt lgkmcnt(0)
    s_barrier
    s_cmp_lg_u32 s3, 0
    s_cbranch_scc1 L_end
    v_lshlrev_b32 v4, 3, v0
    ds_read_b64 v[16:17], v4 offset:0
    ds_read_b64 v[18:19], v4 offset:512
    ds_read_b64 v[20:21], v4 offset:1024
    ds_read_b64 v[22:23], v4 offset:1536
    ds_read_b64 v[24:25], v4 offset:2048
    ds_read_b64 v[26:27], v4 offset:2560
    ds_read_b64 v[28:29], v4 offset:3072
    ds_read_b64 v[30:31], v4 offset:3584
    ds_read_b64 v[32:33], v4 offset:4096
    ds_read_b64 v[34:35], v4 offset:4608
    ds_read_b64 v[36:37], v4 offset:5120
    ds_read_b64 v[38:39], v4 offset:5632
    ds_read_b64 v[40:41], v4 offset:6144
    ds_read_b64 v[42:43], v4 offset:6656
    ds_read_b64 v[44:45], v4 offset:7168
    ds_read_b64 v[46:47], v4 offset:7680
    ds_read_b64 v[120:121], v4 offset:8192
    s_mov_b32 s40, s38
    s_and_b32 s41, s39, 0xffff
    s_mov_b32 s42, 131072
    s_mov_b32 s44, s36
    s_and_b32 s45, s37, 0xffff
    s_mov_b32 s46, 256
    s_mov_b32 s48, s34
    s_and_b32 s49, s35, 0xffff
    s_mov_b32 s50, 32768
    s_lshl_b32 s11, s8, 10
    s_add_u32 s12, s11, s10
    s_xor_b32 s13, s12, 512
    s_lshr_b32 s11, s8, 1
    s_lshl_b32 s11, s11, 2
    s_and_b32 s15, s8, 1
    s_lshl_b32 s15, s15, 4
    s_lshl_b32 s55, 1, s15
    v_mov_b32 v5, s55
    v_mov_b32 v6, s11
    s_lshl_b32 s64, s64, 16
    s_waitcnt lgkmcnt(0)
    v_add_f32 v16, v16, v32
    v_add_f32 v17, v17, v33
    v_add_f32 v18, v18, v34
    v_add_f32 v19, v19, v35
    v_add_f32 v20, v20, v36
    v_add_f32 v21, v21, v37
    v_add_f32 v22, v22, v38
    v_add_f32 v23, v23, v39
    v_add_f32 v24, v24, v40
    v_add_f32 v25, v25, v41
    v_add_f32 v26, v26, v42
    v_add_f32 v27, v27, v43
    v_add_f32 v28, v28, v44
    v_add_f32 v29, v29, v45
    v_add_f32 v30, v30, v46
    v_add_f32 v31, v31, v47
    v_add_f32 v16, v16, v24
    v_add_f32 v17, v17, v25
    v_add_f32 v18, v18, v26
    v_add_f32 v19, v19, v27
    v_add_f32 v20, v20, v28
    v_add_f32 v21, v21, v29
    v_add_f32 v22, v22, v30
    v_add_f32 v23, v23, v31
    v_add_f32 v16, v16, v20
    v_add_f32 v17, v17, v21
    v_add_f32 v18, v18, v22
    v_add_f32 v19, v19, v23
    v_add_f32 v16, v16, v18
    v_add_f32 v17, v17, v19
    buffer_store_dwordx2 v[16:17], v4, s[40:43], s12 offen sc1
    s_mov_b64 s[52:53], exec
    s_waitcnt vmcnt(0)
    s_mov_b64 exec, 1
    buffer_atomic_add v5, v6, s[44:47], 0 offen sc0
    s_waitcnt vmcnt(0)
    s_mov_b64 exec, s[52:53]
    v_readfirstlane_b32 s55, v5
    s_nop 1
    s_lshr_b32 s55, s55, s15
    s_and_b32 s55, s55, 0xffff
    s_cmp_eq_u32 s55, 0
    s_cbranch_scc1 L_end
    buffer_load_dwordx2 v[18:19], v4, s[40:43], s13 offen sc1
    s_lshl_b32 s11, s8, 8
    v_lshlrev_b32 v4, 2, v0
    s_mov_b32 s15, 0xbfb8aa3b
    s_waitcnt vmcnt(0)
    v_add_f32 v16, v16, v18
    v_add_f32 v17, v17, v19
    v_cvt_pk_bf16_f32 v30, v16, v17
    v_lshlrev_b32 v16, 16, v30
    v_and_b32 v17, s14, v30
    v_add_f32 v16, s64, v16
    v_add_f32 v17, s64, v17
    v_cvt_pk_bf16_f32 v30, v16, v17
    v_lshlrev_b32 v16, 16, v30
    v_and_b32 v17, s14, v30
    v_add_f32 v16, v120, v16
    v_add_f32 v17, v121, v17
    v_cvt_pk_bf16_f32 v30, v16, v17
    v_lshlrev_b32 v16, 16, v30
    v_and_b32 v17, s14, v30
    v_mul_f32 v16, s15, v16
    v_mul_f32 v17, s15, v17
    v_exp_f32 v16, v16
    v_exp_f32 v17, v17
    s_nop 0
    v_add_f32 v16, 1.0, v16
    v_add_f32 v17, 1.0, v17
    v_rcp_f32 v16, v16
    v_rcp_f32 v17, v17
    s_nop 0
    v_cvt_pk_bf16_f32 v30, v16, v17
    buffer_store_dword v30, v4, s[48:51], s11 offen
L_end:
    s_endpgm
.section .rodata,"a"
.p2align 6
.amdhsa_kernel standalone__deep_cross_wide_deep__recsys_kernel
  .amdhsa_next_free_vgpr 256
  .amdhsa_next_free_sgpr 102
  .amdhsa_accum_offset 256
  .amdhsa_group_segment_fixed_size 0
  .amdhsa_kernarg_size 96
  .amdhsa_user_sgpr_count 2
  .amdhsa_user_sgpr_kernarg_segment_ptr 1
  .amdhsa_system_sgpr_workgroup_id_x 1
.end_amdhsa_kernel
```
